```python
import torch

def _softmax(x, axis=-1):
    return torch.softmax(x, dim=axis)
def _gelu(x):
    return torch.nn.functional.gelu(x, approximate="tanh")
def _silu(x):
    return torch.nn.functional.silu(x)
def _sigmoid(x):
    return torch.sigmoid(x)
def _layernorm(x, axis=-1, eps=1e-5):
    m = x.mean(dim=axis, keepdim=True)
    v = x.var(dim=axis, keepdim=True, unbiased=False)
    return (x - m) / torch.sqrt(v + eps)
def _scatter_add(tgt, idx, src, axis=0):
    return tgt.clone().index_add_(axis, idx, src)
def _segment_sum(src, seg, n):
    out = torch.zeros((n,) + src.shape[1:], dtype=src.dtype)
    return out.index_add_(0, seg, src)
def _pad(x, pw):
    flat = tuple(v for pair in reversed(pw) for v in pair)
    return torch.nn.functional.pad(x, flat)

kernel_name = 'standalone__kv_cache_quant_int4_int2_kv_with_per_channel_or_per_token_scales__sampling'

def setup_inputs():

    _w = (lambda a: (lambda t: t.to(torch.bfloat16) if t.is_floating_point() else t)(torch.as_tensor(a)))
    B = 32
    Sq = 4
    Skv = 2048
    Hq = 32
    Hkv = 16
    Dh = 128
    bits = 8
    G = 64
    if G <= 0 or G >= Skv:
        G = max(1, Skv // 2)
    Skv = (Skv // G) * G
    ngk = Skv // G
    qmax = (1 << bits) - 1
    return {
        "q": _w((lambda *s: torch.randn(*s, dtype=torch.bfloat16) * 0.2)(B, Hq, Sq, Dh)),
        "qk": _w(torch.randint(0, qmax + 1, (B, Hkv, Skv, Dh)).to(torch.int32)),
        "qv": _w(torch.randint(0, qmax + 1, (B, Hkv, Skv, Dh)).to(torch.int32)),
        "k_scales": _w(torch.abs((lambda *s: torch.randn(*s, dtype=torch.bfloat16) * 0.2)(B, Hkv, ngk, Dh)) * 0.05 + 0.02),
        "k_zeros": _w((lambda *s: torch.randn(*s, dtype=torch.bfloat16) * 0.2)(B, Hkv, ngk, Dh) + float(qmax) / 2.0),
        "v_scales": _w(torch.abs((lambda *s: torch.randn(*s, dtype=torch.bfloat16) * 0.05)(B, Hkv, Skv, 1)) * 0.05 + 0.02),
        "v_zeros": _w((lambda *s: torch.randn(*s, dtype=torch.bfloat16) * 0.05)(B, Hkv, Skv, 1) + float(qmax) / 2.0),
    }

def reference(q, qk, qv, k_scales, k_zeros, v_scales, v_zeros):
    B, Hq, Sq, Dh = q.shape
    Hkv, Skv = qk.shape[1], qk.shape[2]
    ngk = k_scales.shape[2]
    G = Skv // ngk
    ks = (lambda x, n, axis: torch.repeat_interleave(x, n, dim=axis))(k_scales, G, axis=2)
    kz = (lambda x, n, axis: torch.repeat_interleave(x, n, dim=axis))(k_zeros, G, axis=2)
    k = ((lambda x, dt: x.to(dt))(qk, q.dtype) - kz) * ks
    v = ((lambda x, dt: x.to(dt))(qv, q.dtype) - v_zeros) * v_scales
    rep = Hq // Hkv
    if rep > 1:
        k = (lambda x, n, axis: torch.repeat_interleave(x, n, dim=axis))(k, rep, axis=1)
        v = (lambda x, n, axis: torch.repeat_interleave(x, n, dim=axis))(v, rep, axis=1)
    scale = float(Dh) ** -0.5
    logits = torch.einsum("bhqd,bhkd->bhqk", q, k) * scale
    p = _softmax(logits, axis=-1)
    o = torch.einsum("bhqk,bhkd->bhqd", p, v)
    return o
```

```asm
; @launch grid=(256,1,1) block=(320,1,1) lds=146560
.amdgcn_target "amdgcn-amd-amdhsa--gfx950"
.text
.globl standalone__kv_cache_quant_int4_int2_kv_with_per_channel_or_per_token_scales__sampling_kernel
.p2align 8
.type standalone__kv_cache_quant_int4_int2_kv_with_per_channel_or_per_token_scales__sampling_kernel,@function
standalone__kv_cache_quant_int4_int2_kv_with_per_channel_or_per_token_scales__sampling_kernel:
  s_cmp_ge_u32 s2, 256
  s_cbranch_scc1 L_end
  s_load_dwordx16 s[4:19], s[0:1], 0
  s_load_dwordx2 s[80:81], s[0:1], 72
  v_lshrrev_b32 v1, 6, v0
  v_and_b32 v0, 63, v0
  v_readfirstlane_b32 s3, v1
  s_nop 0
  s_cmp_lg_u32 s3, 0
  s_nop 2
  s_cbranch_scc1 L_cons
  s_setprio 3
  v_lshlrev_b32 v3, 4, v0
  v_and_b32 v8, 15, v0
  v_and_b32 v9, 7, v0
  s_lshl_b32 s52, s2, 14
  s_lshl_b32 s53, s2, 13
  v_lshlrev_b32 v8, 4, v8
  v_lshlrev_b32 v9, 4, v9
  v_add_u32 v8, s52, v8
  v_add_u32 v9, s53, v9
  v_cmp_gt_u32 vcc, 32, v0
  s_nop 1
  v_cndmask_b32 v8, v9, v8, vcc
  v_mov_b32 v10, 128
  v_mov_b32 v11, 256
  v_cndmask_b32 v10, v10, v11, vcc
  v_mov_b32 v11, 0
  v_mov_b32 v9, 0
  v_cmp_le_u32 s[32:33], 16, v0
  v_cmp_le_u32 s[34:35], 32, v0
  v_cmp_le_u32 s[36:37], 40, v0
  v_lshrrev_b32 v4, 5, v0
  v_and_b32 v5, 31, v0
  v_add_u32 v6, 0, v4
  v_xor_b32 v6, v6, v5
  v_lshlrev_b32 v6, 4, v6
  v_lshl_add_u32 v16, v4, 9, v6
  v_add_u32 v6, 2, v4
  v_xor_b32 v6, v6, v5
  v_lshlrev_b32 v6, 4, v6
  v_lshl_add_u32 v17, v4, 9, v6
  v_add_u32 v6, 4, v4
  v_xor_b32 v6, v6, v5
  v_lshlrev_b32 v6, 4, v6
  v_lshl_add_u32 v18, v4, 9, v6
  v_add_u32 v6, 6, v4
  v_xor_b32 v6, v6, v5
  v_lshlrev_b32 v6, 4, v6
  v_lshl_add_u32 v19, v4, 9, v6
  v_add_u32 v6, 8, v4
  v_xor_b32 v6, v6, v5
  v_lshlrev_b32 v6, 4, v6
  v_lshl_add_u32 v20, v4, 9, v6
  v_add_u32 v6, 10, v4
  v_xor_b32 v6, v6, v5
  v_lshlrev_b32 v6, 4, v6
  v_lshl_add_u32 v21, v4, 9, v6
  v_add_u32 v6, 12, v4
  v_xor_b32 v6, v6, v5
  v_lshlrev_b32 v6, 4, v6
  v_lshl_add_u32 v22, v4, 9, v6
  v_add_u32 v6, 14, v4
  v_xor_b32 v6, v6, v5
  v_lshlrev_b32 v6, 4, v6
  v_lshl_add_u32 v23, v4, 9, v6
  s_lshl_b32 s52, s2, 12
  s_add_u32 s53, s52, 0
  v_mul_u32_u24 v26, 8160, v10
  v_mov_b32 v27, 0
  s_mov_b32 m0, 139264
  s_mov_b32 s30, 0x100000
  s_mov_b32 s31, 0x20000
  s_waitcnt lgkmcnt(0)
  s_mov_b32 s28, s4
  s_and_b32 s29, s5, 0xffff
  buffer_load_dwordx4 v3, s[28:31], s52 offen offset:0 nt lds
  buffer_load_dwordx4 v3, s[28:31], s52 offen offset:1024 nt lds
  buffer_load_dwordx4 v3, s[28:31], s53 offen offset:2048 nt lds
  buffer_load_dwordx4 v3, s[28:31], s53 offen offset:3072 nt lds
  v_mov_b32 v12, s10
  v_mov_b32 v13, s11
  v_mov_b32 v14, s12
  v_mov_b32 v15, s13
  v_cndmask_b32 v12, v12, v14, s[32:33]
  v_cndmask_b32 v13, v13, v15, s[32:33]
  v_mov_b32 v14, s14
  v_mov_b32 v15, s15
  v_cndmask_b32 v12, v12, v14, s[34:35]
  v_cndmask_b32 v13, v13, v15, s[34:35]
  v_mov_b32 v14, s16
  v_mov_b32 v15, s17
  v_cndmask_b32 v12, v12, v14, s[36:37]
  v_cndmask_b32 v13, v13, v15, s[36:37]
  v_lshl_add_u64 v[12:13], v[8:9], 0, v[12:13]
  s_mov_b32 exec_hi, 0xffff
  s_mov_b32 s55, 64
  s_mov_b32 s54, 65536
L_rec:
  s_mov_b32 m0, s54
  s_waitcnt vmcnt(27)
  global_load_lds_dwordx4 v[12:13], off nt
  v_lshl_add_u64 v[12:13], v[10:11], 0, v[12:13]
  s_add_u32 s54, s54, 1024
  s_sub_u32 s55, s55, 1
  s_cmp_lg_u32 s55, 0
  s_cbranch_scc1 L_rec
  s_mov_b32 exec_hi, -1
  s_mov_b32 s20, s6
  s_and_b32 s21, s7, 0xffff
  s_mov_b32 s22, 0x20000000
  s_mov_b32 s23, 0x20000
  s_mov_b32 s24, s8
  s_and_b32 s25, s9, 0xffff
  s_mov_b32 s26, 0x20000000
  s_mov_b32 s27, 0x20000
  s_mov_b32 s54, 0
  s_lshr_b32 s57, s2, 3
  s_mul_i32 s57, s57, 17408
  s_add_u32 s82, s80, s57
  s_addc_u32 s83, s81, 0
  s_add_u32 s82, s82, 1048576
  s_addc_u32 s83, s83, 0
  s_mov_b32 s56, 1
  s_lshl_b32 s53, s2, 21
  s_mov_b32 s55, 64
L_ld_k:
L_ld_k_1:
  s_add_u32 s52, s53, 0
  s_add_u32 m0, s54, 0
  s_waitcnt vmcnt(19)
  buffer_load_dwordx4 v16, s[20:23], s52 offen offset:0 nt lds
  s_waitcnt vmcnt(19)
  buffer_load_dwordx4 v17, s[20:23], s52 offen offset:1024 nt lds
  s_waitcnt vmcnt(19)
  buffer_load_dwordx4 v18, s[20:23], s52 offen offset:2048 nt lds
  s_waitcnt vmcnt(19)
  buffer_load_dwordx4 v19, s[20:23], s52 offen offset:3072 nt lds
  s_add_u32 s52, s53, 4096
  s_add_u32 m0, s54, 4096
  s_waitcnt vmcnt(19)
  buffer_load_dwordx4 v20, s[20:23], s52 offen offset:0 nt lds
  s_waitcnt vmcnt(19)
  buffer_load_dwordx4 v21, s[20:23], s52 offen offset:1024 nt lds
  s_waitcnt vmcnt(19)
  buffer_load_dwordx4 v22, s[20:23], s52 offen offset:2048 nt lds
  s_waitcnt vmcnt(19)
  buffer_load_dwordx4 v23, s[20:23], s52 offen offset:3072 nt lds
  s_add_u32 s52, s53, 8192
  s_add_u32 m0, s54, 8192
  s_waitcnt vmcnt(19)
  buffer_load_dwordx4 v16, s[20:23], s52 offen offset:0 nt lds
  s_waitcnt vmcnt(19)
  buffer_load_dwordx4 v17, s[20:23], s52 offen offset:1024 nt lds
  s_waitcnt vmcnt(19)
  buffer_load_dwordx4 v18, s[20:23], s52 offen offset:2048 nt lds
  s_waitcnt vmcnt(19)
  buffer_load_dwordx4 v19, s[20:23], s52 offen offset:3072 nt lds
  s_add_u32 s52, s53, 12288
  s_add_u32 m0, s54, 12288
  s_waitcnt vmcnt(19)
  buffer_load_dwordx4 v20, s[20:23], s52 offen offset:0 nt lds
  s_waitcnt vmcnt(19)
  buffer_load_dwordx4 v21, s[20:23], s52 offen offset:1024 nt lds
  s_waitcnt vmcnt(19)
  buffer_load_dwordx4 v22, s[20:23], s52 offen offset:2048 nt lds
  s_waitcnt vmcnt(19)
  buffer_load_dwordx4 v23, s[20:23], s52 offen offset:3072 nt lds
  s_add_u32 s52, s53, 16384
  s_add_u32 m0, s54, 16384
  s_waitcnt vmcnt(19)
  buffer_load_dwordx4 v16, s[20:23], s52 offen offset:0 nt lds
  s_waitcnt vmcnt(19)
  buffer_load_dwordx4 v17, s[20:23], s52 offen offset:1024 nt lds
  s_waitcnt vmcnt(19)
  buffer_load_dwordx4 v18, s[20:23], s52 offen offset:2048 nt lds
  s_waitcnt vmcnt(19)
  s_barrier
  buffer_load_dwordx4 v19, s[20:23], s52 offen offset:3072 nt lds
  s_add_u32 s52, s53, 20480
  s_add_u32 m0, s54, 20480
  s_waitcnt vmcnt(19)
  buffer_load_dwordx4 v20, s[20:23], s52 offen offset:0 nt lds
  s_waitcnt vmcnt(19)
  buffer_load_dwordx4 v21, s[20:23], s52 offen offset:1024 nt lds
  s_waitcnt vmcnt(19)
  buffer_load_dwordx4 v22, s[20:23], s52 offen offset:2048 nt lds
  s_waitcnt vmcnt(19)
  buffer_load_dwordx4 v23, s[20:23], s52 offen offset:3072 nt lds
  s_add_u32 s52, s53, 24576
  s_add_u32 m0, s54, 24576
  s_waitcnt vmcnt(19)
  buffer_load_dwordx4 v16, s[20:23], s52 offen offset:0 nt lds
  s_waitcnt vmcnt(19)
  buffer_load_dwordx4 v17, s[20:23], s52 offen offset:1024 nt lds
  s_waitcnt vmcnt(19)
  buffer_load_dwordx4 v18, s[20:23], s52 offen offset:2048 nt lds
  s_waitcnt vmcnt(19)
  buffer_load_dwordx4 v19, s[20:23], s52 offen offset:3072 nt lds
  s_add_u32 s52, s53, 28672
  s_add_u32 m0, s54, 28672
  s_waitcnt vmcnt(19)
  buffer_load_dwordx4 v20, s[20:23], s52 offen offset:0 nt lds
  s_waitcnt vmcnt(19)
  buffer_load_dwordx4 v21, s[20:23], s52 offen offset:1024 nt lds
  s_waitcnt vmcnt(19)
  buffer_load_dwordx4 v22, s[20:23], s52 offen offset:2048 nt lds
  s_waitcnt vmcnt(19)
  buffer_load_dwordx4 v23, s[20:23], s52 offen offset:3072 nt lds
  s_xor_b32 s54, s54, 32768
  s_add_u32 s53, s53, 32768
  s_sub_u32 s55, s55, 1
  s_cmp_lg_u32 s55, 0
  s_barrier
  s_cbranch_scc1 L_ld_k
L_ld_k_done:
  s_mov_b32 s56, 1
  s_lshl_b32 s53, s2, 21
  s_mov_b32 s55, 64
L_ld_v:
  s_cmp_lg_u32 s55, 48
  s_cbranch_scc1 L_c1_0
  s_mov_b32 s84, 1
  s_atomic_add s84, s[82:83], 0x0 glc
L_c1_0:
  s_cmp_lg_u32 s55, 46
  s_cbranch_scc1 L_c2_0
  s_waitcnt lgkmcnt(0)
  s_mov_b32 s56, 0
  s_cmp_ge_u32 s84, 1
  s_cselect_b32 s56, 1, s56
  s_cmp_ge_u32 s84, 6
  s_cselect_b32 s56, 2, s56
  s_cmp_ge_u32 s84, 7
  s_cselect_b32 s56, 3, s56
  s_cmp_ge_u32 s84, 8
  s_cselect_b32 s56, 1, s56
L_c2_0:
  s_cmp_lg_u32 s55, 32
  s_cbranch_scc1 L_c1_1
  s_mov_b32 s84, 1
  s_atomic_add s84, s[82:83], 0x1100 glc
L_c1_1:
  s_cmp_lg_u32 s55, 30
  s_cbranch_scc1 L_c2_1
  s_waitcnt lgkmcnt(0)
  s_mov_b32 s56, 0
  s_cmp_ge_u32 s84, 2
  s_cselect_b32 s56, 1, s56
  s_cmp_ge_u32 s84, 6
  s_cselect_b32 s56, 2, s56
  s_cmp_ge_u32 s84, 7
  s_cselect_b32 s56, 3, s56
  s_cmp_ge_u32 s84, 8
  s_cselect_b32 s56, 1, s56
L_c2_1:
  s_cmp_lg_u32 s55, 20
  s_cbranch_scc1 L_c1_2
  s_mov_b32 s84, 1
  s_atomic_add s84, s[82:83], 0x2200 glc
L_c1_2:
  s_cmp_lg_u32 s55, 18
  s_cbranch_scc1 L_c2_2
  s_waitcnt lgkmcnt(0)
  s_mov_b32 s56, 0
  s_cmp_ge_u32 s84, 2
  s_cselect_b32 s56, 1, s56
  s_cmp_ge_u32 s84, 6
  s_cselect_b32 s56, 2, s56
  s_cmp_ge_u32 s84, 7
  s_cselect_b32 s56, 3, s56
  s_cmp_ge_u32 s84, 8
  s_cselect_b32 s56, 1, s56
L_c2_2:
  s_cmp_lg_u32 s55, 11
  s_cbranch_scc1 L_c1_3
  s_mov_b32 s84, 1
  s_atomic_add s84, s[82:83], 0x3300 glc
L_c1_3:
  s_cmp_lg_u32 s55, 9
  s_cbranch_scc1 L_c2_3
  s_waitcnt lgkmcnt(0)
  s_mov_b32 s56, 0
  s_cmp_ge_u32 s84, 2
  s_cselect_b32 s56, 1, s56
  s_cmp_ge_u32 s84, 6
  s_cselect_b32 s56, 2, s56
  s_cmp_ge_u32 s84, 7
  s_cselect_b32 s56, 3, s56
  s_cmp_ge_u32 s84, 8
  s_cselect_b32 s56, 1, s56
L_c2_3:
  s_cmp_eq_u32 s56, 0
  s_cbranch_scc1 L_ld_v_0
  s_cmp_eq_u32 s56, 2
  s_cbranch_scc1 L_ld_v_2
  s_cmp_eq_u32 s56, 3
  s_cbranch_scc1 L_ld_v_3
L_ld_v_1:
  s_add_u32 s52, s53, 0
  s_add_u32 m0, s54, 0
  s_waitcnt vmcnt(19)
  buffer_load_dwordx4 v3, s[24:27], s52 offen offset:0 nt lds
  s_waitcnt vmcnt(19)
  buffer_load_dwordx4 v3, s[24:27], s52 offen offset:1024 nt lds
  s_waitcnt vmcnt(19)
  buffer_load_dwordx4 v3, s[24:27], s52 offen offset:2048 nt lds
  s_waitcnt vmcnt(19)
  buffer_load_dwordx4 v3, s[24:27], s52 offen offset:3072 nt lds
  s_add_u32 s52, s53, 4096
  s_add_u32 m0, s54, 4096
  s_waitcnt vmcnt(19)
  buffer_load_dwordx4 v3, s[24:27], s52 offen offset:0 nt lds
  s_waitcnt vmcnt(19)
  buffer_load_dwordx4 v3, s[24:27], s52 offen offset:1024 nt lds
  s_waitcnt vmcnt(19)
  buffer_load_dwordx4 v3, s[24:27], s52 offen offset:2048 nt lds
  s_waitcnt vmcnt(19)
  buffer_load_dwordx4 v3, s[24:27], s52 offen offset:3072 nt lds
  s_add_u32 s52, s53, 8192
  s_add_u32 m0, s54, 8192
  s_waitcnt vmcnt(19)
  buffer_load_dwordx4 v3, s[24:27], s52 offen offset:0 nt lds
  s_waitcnt vmcnt(19)
  buffer_load_dwordx4 v3, s[24:27], s52 offen offset:1024 nt lds
  s_waitcnt vmcnt(19)
  buffer_load_dwordx4 v3, s[24:27], s52 offen offset:2048 nt lds
  s_waitcnt vmcnt(19)
  buffer_load_dwordx4 v3, s[24:27], s52 offen offset:3072 nt lds
  s_add_u32 s52, s53, 12288
  s_add_u32 m0, s54, 12288
  s_waitcnt vmcnt(19)
  buffer_load_dwordx4 v3, s[24:27], s52 offen offset:0 nt lds
  s_waitcnt vmcnt(19)
  buffer_load_dwordx4 v3, s[24:27], s52 offen offset:1024 nt lds
  s_waitcnt vmcnt(19)
  buffer_load_dwordx4 v3, s[24:27], s52 offen offset:2048 nt lds
  s_waitcnt vmcnt(19)
  buffer_load_dwordx4 v3, s[24:27], s52 offen offset:3072 nt lds
  s_add_u32 s52, s53, 16384
  s_add_u32 m0, s54, 16384
  s_waitcnt vmcnt(19)
  buffer_load_dwordx4 v3, s[24:27], s52 offen offset:0 nt lds
  s_waitcnt vmcnt(19)
  buffer_load_dwordx4 v3, s[24:27], s52 offen offset:1024 nt lds
  s_waitcnt vmcnt(19)
  buffer_load_dwordx4 v3, s[24:27], s52 offen offset:2048 nt lds
  s_waitcnt vmcnt(19)
  s_barrier
  buffer_load_dwordx4 v3, s[24:27], s52 offen offset:3072 nt lds
  s_add_u32 s52, s53, 20480
  s_add_u32 m0, s54, 20480
  s_waitcnt vmcnt(19)
  buffer_load_dwordx4 v3, s[24:27], s52 offen offset:0 nt lds
  s_waitcnt vmcnt(19)
  buffer_load_dwordx4 v3, s[24:27], s52 offen offset:1024 nt lds
  s_waitcnt vmcnt(19)
  buffer_load_dwordx4 v3, s[24:27], s52 offen offset:2048 nt lds
  s_waitcnt vmcnt(19)
  buffer_load_dwordx4 v3, s[24:27], s52 offen offset:3072 nt lds
  s_add_u32 s52, s53, 24576
  s_add_u32 m0, s54, 24576
  s_waitcnt vmcnt(19)
  buffer_load_dwordx4 v3, s[24:27], s52 offen offset:0 nt lds
  s_waitcnt vmcnt(19)
  buffer_load_dwordx4 v3, s[24:27], s52 offen offset:1024 nt lds
  s_waitcnt vmcnt(19)
  buffer_load_dwordx4 v3, s[24:27], s52 offen offset:2048 nt lds
  s_waitcnt vmcnt(19)
  buffer_load_dwordx4 v3, s[24:27], s52 offen offset:3072 nt lds
  s_add_u32 s52, s53, 28672
  s_add_u32 m0, s54, 28672
  s_waitcnt vmcnt(19)
  buffer_load_dwordx4 v3, s[24:27], s52 offen offset:0 nt lds
  s_waitcnt vmcnt(19)
  buffer_load_dwordx4 v3, s[24:27], s52 offen offset:1024 nt lds
  s_waitcnt vmcnt(19)
  buffer_load_dwordx4 v3, s[24:27], s52 offen offset:2048 nt lds
  s_waitcnt vmcnt(19)
  buffer_load_dwordx4 v3, s[24:27], s52 offen offset:3072 nt lds
  s_xor_b32 s54, s54, 32768
  s_add_u32 s53, s53, 32768
  s_sub_u32 s55, s55, 1
  s_cmp_lg_u32 s55, 4
  s_barrier
  s_cbranch_scc1 L_ld_v
  s_branch L_ld_v_done
L_ld_v_0:
  s_add_u32 s52, s53, 0
  s_add_u32 m0, s54, 0
  s_waitcnt vmcnt(17)
  buffer_load_dwordx4 v3, s[24:27], s52 offen offset:0 nt lds
  s_waitcnt vmcnt(17)
  buffer_load_dwordx4 v3, s[24:27], s52 offen offset:1024 nt lds
  s_waitcnt vmcnt(17)
  buffer_load_dwordx4 v3, s[24:27], s52 offen offset:2048 nt lds
  s_waitcnt vmcnt(17)
  buffer_load_dwordx4 v3, s[24:27], s52 offen offset:3072 nt lds
  s_add_u32 s52, s53, 4096
  s_add_u32 m0, s54, 4096
  s_waitcnt vmcnt(17)
  buffer_load_dwordx4 v3, s[24:27], s52 offen offset:0 nt lds
  s_waitcnt vmcnt(17)
  buffer_load_dwordx4 v3, s[24:27], s52 offen offset:1024 nt lds
  s_waitcnt vmcnt(17)
  buffer_load_dwordx4 v3, s[24:27], s52 offen offset:2048 nt lds
  s_waitcnt vmcnt(17)
  buffer_load_dwordx4 v3, s[24:27], s52 offen offset:3072 nt lds
  s_add_u32 s52, s53, 8192
  s_add_u32 m0, s54, 8192
  s_waitcnt vmcnt(17)
  buffer_load_dwordx4 v3, s[24:27], s52 offen offset:0 nt lds
  s_waitcnt vmcnt(17)
  buffer_load_dwordx4 v3, s[24:27], s52 offen offset:1024 nt lds
  s_waitcnt vmcnt(17)
  buffer_load_dwordx4 v3, s[24:27], s52 offen offset:2048 nt lds
  s_waitcnt vmcnt(17)
  buffer_load_dwordx4 v3, s[24:27], s52 offen offset:3072 nt lds
  s_add_u32 s52, s53, 12288
  s_add_u32 m0, s54, 12288
  s_waitcnt vmcnt(17)
  buffer_load_dwordx4 v3, s[24:27], s52 offen offset:0 nt lds
  s_waitcnt vmcnt(17)
  buffer_load_dwordx4 v3, s[24:27], s52 offen offset:1024 nt lds
  s_waitcnt vmcnt(17)
  buffer_load_dwordx4 v3, s[24:27], s52 offen offset:2048 nt lds
  s_waitcnt vmcnt(17)
  buffer_load_dwordx4 v3, s[24:27], s52 offen offset:3072 nt lds
  s_add_u32 s52, s53, 16384
  s_add_u32 m0, s54, 16384
  s_waitcnt vmcnt(17)
  buffer_load_dwordx4 v3, s[24:27], s52 offen offset:0 nt lds
  s_waitcnt vmcnt(17)
  s_barrier
  buffer_load_dwordx4 v3, s[24:27], s52 offen offset:1024 nt lds
  s_waitcnt vmcnt(17)
  buffer_load_dwordx4 v3, s[24:27], s52 offen offset:2048 nt lds
  s_waitcnt vmcnt(17)
  buffer_load_dwordx4 v3, s[24:27], s52 offen offset:3072 nt lds
  s_add_u32 s52, s53, 20480
  s_add_u32 m0, s54, 20480
  s_waitcnt vmcnt(17)
  buffer_load_dwordx4 v3, s[24:27], s52 offen offset:0 nt lds
  s_waitcnt vmcnt(17)
  buffer_load_dwordx4 v3, s[24:27], s52 offen offset:1024 nt lds
  s_waitcnt vmcnt(17)
  buffer_load_dwordx4 v3, s[24:27], s52 offen offset:2048 nt lds
  s_waitcnt vmcnt(17)
  buffer_load_dwordx4 v3, s[24:27], s52 offen offset:3072 nt lds
  s_add_u32 s52, s53, 24576
  s_add_u32 m0, s54, 24576
  s_waitcnt vmcnt(17)
  buffer_load_dwordx4 v3, s[24:27], s52 offen offset:0 nt lds
  s_waitcnt vmcnt(17)
  buffer_load_dwordx4 v3, s[24:27], s52 offen offset:1024 nt lds
  s_waitcnt vmcnt(17)
  buffer_load_dwordx4 v3, s[24:27], s52 offen offset:2048 nt lds
  s_waitcnt vmcnt(17)
  buffer_load_dwordx4 v3, s[24:27], s52 offen offset:3072 nt lds
  s_add_u32 s52, s53, 28672
  s_add_u32 m0, s54, 28672
  s_waitcnt vmcnt(17)
  buffer_load_dwordx4 v3, s[24:27], s52 offen offset:0 nt lds
  s_waitcnt vmcnt(17)
  buffer_load_dwordx4 v3, s[24:27], s52 offen offset:1024 nt lds
  s_waitcnt vmcnt(17)
  buffer_load_dwordx4 v3, s[24:27], s52 offen offset:2048 nt lds
  s_waitcnt vmcnt(17)
  buffer_load_dwordx4 v3, s[24:27], s52 offen offset:3072 nt lds
  s_xor_b32 s54, s54, 32768
  s_add_u32 s53, s53, 32768
  s_sub_u32 s55, s55, 1
  s_cmp_lg_u32 s55, 4
  s_barrier
  s_cbranch_scc1 L_ld_v
  s_branch L_ld_v_done
L_ld_v_2:
  s_add_u32 s52, s53, 0
  s_add_u32 m0, s54, 0
  s_waitcnt vmcnt(21)
  buffer_load_dwordx4 v3, s[24:27], s52 offen offset:0 nt lds
  s_waitcnt vmcnt(21)
  buffer_load_dwordx4 v3, s[24:27], s52 offen offset:1024 nt lds
  s_waitcnt vmcnt(21)
  buffer_load_dwordx4 v3, s[24:27], s52 offen offset:2048 nt lds
  s_waitcnt vmcnt(21)
  buffer_load_dwordx4 v3, s[24:27], s52 offen offset:3072 nt lds
  s_add_u32 s52, s53, 4096
  s_add_u32 m0, s54, 4096
  s_waitcnt vmcnt(21)
  buffer_load_dwordx4 v3, s[24:27], s52 offen offset:0 nt lds
  s_waitcnt vmcnt(21)
  buffer_load_dwordx4 v3, s[24:27], s52 offen offset:1024 nt lds
  s_waitcnt vmcnt(21)
  buffer_load_dwordx4 v3, s[24:27], s52 offen offset:2048 nt lds
  s_waitcnt vmcnt(21)
  buffer_load_dwordx4 v3, s[24:27], s52 offen offset:3072 nt lds
  s_add_u32 s52, s53, 8192
  s_add_u32 m0, s54, 8192
  s_waitcnt vmcnt(21)
  buffer_load_dwordx4 v3, s[24:27], s52 offen offset:0 nt lds
  s_waitcnt vmcnt(21)
  buffer_load_dwordx4 v3, s[24:27], s52 offen offset:1024 nt lds
  s_waitcnt vmcnt(21)
  buffer_load_dwordx4 v3, s[24:27], s52 offen offset:2048 nt lds
  s_waitcnt vmcnt(21)
  buffer_load_dwordx4 v3, s[24:27], s52 offen offset:3072 nt lds
  s_add_u32 s52, s53, 12288
  s_add_u32 m0, s54, 12288
  s_waitcnt vmcnt(21)
  buffer_load_dwordx4 v3, s[24:27], s52 offen offset:0 nt lds
  s_waitcnt vmcnt(21)
  buffer_load_dwordx4 v3, s[24:27], s52 offen offset:1024 nt lds
  s_waitcnt vmcnt(21)
  buffer_load_dwordx4 v3, s[24:27], s52 offen offset:2048 nt lds
  s_waitcnt vmcnt(21)
  buffer_load_dwordx4 v3, s[24:27], s52 offen offset:3072 nt lds
  s_add_u32 s52, s53, 16384
  s_add_u32 m0, s54, 16384
  s_waitcnt vmcnt(21)
  buffer_load_dwordx4 v3, s[24:27], s52 offen offset:0 nt lds
  s_waitcnt vmcnt(21)
  buffer_load_dwordx4 v3, s[24:27], s52 offen offset:1024 nt lds
  s_waitcnt vmcnt(21)
  buffer_load_dwordx4 v3, s[24:27], s52 offen offset:2048 nt lds
  s_waitcnt vmcnt(21)
  buffer_load_dwordx4 v3, s[24:27], s52 offen offset:3072 nt lds
  s_add_u32 s52, s53, 20480
  s_add_u32 m0, s54, 20480
  s_waitcnt vmcnt(21)
  buffer_load_dwordx4 v3, s[24:27], s52 offen offset:0 nt lds
  s_waitcnt vmcnt(21)
  s_barrier
  buffer_load_dwordx4 v3, s[24:27], s52 offen offset:1024 nt lds
  s_waitcnt vmcnt(21)
  buffer_load_dwordx4 v3, s[24:27], s52 offen offset:2048 nt lds
  s_waitcnt vmcnt(21)
  buffer_load_dwordx4 v3, s[24:27], s52 offen offset:3072 nt lds
  s_add_u32 s52, s53, 24576
  s_add_u32 m0, s54, 24576
  s_waitcnt vmcnt(21)
  buffer_load_dwordx4 v3, s[24:27], s52 offen offset:0 nt lds
  s_waitcnt vmcnt(21)
  buffer_load_dwordx4 v3, s[24:27], s52 offen offset:1024 nt lds
  s_waitcnt vmcnt(21)
  buffer_load_dwordx4 v3, s[24:27], s52 offen offset:2048 nt lds
  s_waitcnt vmcnt(21)
  buffer_load_dwordx4 v3, s[24:27], s52 offen offset:3072 nt lds
  s_add_u32 s52, s53, 28672
  s_add_u32 m0, s54, 28672
  s_waitcnt vmcnt(21)
  buffer_load_dwordx4 v3, s[24:27], s52 offen offset:0 nt lds
  s_waitcnt vmcnt(21)
  buffer_load_dwordx4 v3, s[24:27], s52 offen offset:1024 nt lds
  s_waitcnt vmcnt(21)
  buffer_load_dwordx4 v3, s[24:27], s52 offen offset:2048 nt lds
  s_waitcnt vmcnt(21)
  buffer_load_dwordx4 v3, s[24:27], s52 offen offset:3072 nt lds
  s_xor_b32 s54, s54, 32768
  s_add_u32 s53, s53, 32768
  s_sub_u32 s55, s55, 1
  s_cmp_lg_u32 s55, 4
  s_barrier
  s_cbranch_scc1 L_ld_v
  s_branch L_ld_v_done
L_ld_v_3:
  s_add_u32 s52, s53, 0
  s_add_u32 m0, s54, 0
  s_waitcnt vmcnt(23)
  buffer_load_dwordx4 v3, s[24:27], s52 offen offset:0 nt lds
  s_waitcnt vmcnt(23)
  buffer_load_dwordx4 v3, s[24:27], s52 offen offset:1024 nt lds
  s_waitcnt vmcnt(23)
  buffer_load_dwordx4 v3, s[24:27], s52 offen offset:2048 nt lds
  s_waitcnt vmcnt(23)
  buffer_load_dwordx4 v3, s[24:27], s52 offen offset:3072 nt lds
  s_add_u32 s52, s53, 4096
  s_add_u32 m0, s54, 4096
  s_waitcnt vmcnt(23)
  buffer_load_dwordx4 v3, s[24:27], s52 offen offset:0 nt lds
  s_waitcnt vmcnt(23)
  buffer_load_dwordx4 v3, s[24:27], s52 offen offset:1024 nt lds
  s_waitcnt vmcnt(23)
  buffer_load_dwordx4 v3, s[24:27], s52 offen offset:2048 nt lds
  s_waitcnt vmcnt(23)
  buffer_load_dwordx4 v3, s[24:27], s52 offen offset:3072 nt lds
  s_add_u32 s52, s53, 8192
  s_add_u32 m0, s54, 8192
  s_waitcnt vmcnt(23)
  buffer_load_dwordx4 v3, s[24:27], s52 offen offset:0 nt lds
  s_waitcnt vmcnt(23)
  buffer_load_dwordx4 v3, s[24:27], s52 offen offset:1024 nt lds
  s_waitcnt vmcnt(23)
  buffer_load_dwordx4 v3, s[24:27], s52 offen offset:2048 nt lds
  s_waitcnt vmcnt(23)
  buffer_load_dwordx4 v3, s[24:27], s52 offen offset:3072 nt lds
  s_add_u32 s52, s53, 12288
  s_add_u32 m0, s54, 12288
  s_waitcnt vmcnt(23)
  buffer_load_dwordx4 v3, s[24:27], s52 offen offset:0 nt lds
  s_waitcnt vmcnt(23)
  buffer_load_dwordx4 v3, s[24:27], s52 offen offset:1024 nt lds
  s_waitcnt vmcnt(23)
  buffer_load_dwordx4 v3, s[24:27], s52 offen offset:2048 nt lds
  s_waitcnt vmcnt(23)
  buffer_load_dwordx4 v3, s[24:27], s52 offen offset:3072 nt lds
  s_add_u32 s52, s53, 16384
  s_add_u32 m0, s54, 16384
  s_waitcnt vmcnt(23)
  buffer_load_dwordx4 v3, s[24:27], s52 offen offset:0 nt lds
  s_waitcnt vmcnt(23)
  buffer_load_dwordx4 v3, s[24:27], s52 offen offset:1024 nt lds
  s_waitcnt vmcnt(23)
  buffer_load_dwordx4 v3, s[24:27], s52 offen offset:2048 nt lds
  s_waitcnt vmcnt(23)
  buffer_load_dwordx4 v3, s[24:27], s52 offen offset:3072 nt lds
  s_add_u32 s52, s53, 20480
  s_add_u32 m0, s54, 20480
  s_waitcnt vmcnt(23)
  buffer_load_dwordx4 v3, s[24:27], s52 offen offset:0 nt lds
  s_waitcnt vmcnt(23)
  buffer_load_dwordx4 v3, s[24:27], s52 offen offset:1024 nt lds
  s_waitcnt vmcnt(23)
  buffer_load_dwordx4 v3, s[24:27], s52 offen offset:2048 nt lds
  s_waitcnt vmcnt(23)
  s_barrier
  buffer_load_dwordx4 v3, s[24:27], s52 offen offset:3072 nt lds
  s_add_u32 s52, s53, 24576
  s_add_u32 m0, s54, 24576
  s_waitcnt vmcnt(23)
  buffer_load_dwordx4 v3, s[24:27], s52 offen offset:0 nt lds
  s_waitcnt vmcnt(23)
  buffer_load_dwordx4 v3, s[24:27], s52 offen offset:1024 nt lds
  s_waitcnt vmcnt(23)
  buffer_load_dwordx4 v3, s[24:27], s52 offen offset:2048 nt lds
  s_waitcnt vmcnt(23)
  buffer_load_dwordx4 v3, s[24:27], s52 offen offset:3072 nt lds
  s_add_u32 s52, s53, 28672
  s_add_u32 m0, s54, 28672
  s_waitcnt vmcnt(23)
  buffer_load_dwordx4 v3, s[24:27], s52 offen offset:0 nt lds
  s_waitcnt vmcnt(23)
  buffer_load_dwordx4 v3, s[24:27], s52 offen offset:1024 nt lds
  s_waitcnt vmcnt(23)
  buffer_load_dwordx4 v3, s[24:27], s52 offen offset:2048 nt lds
  s_waitcnt vmcnt(23)
  buffer_load_dwordx4 v3, s[24:27], s52 offen offset:3072 nt lds
  s_xor_b32 s54, s54, 32768
  s_add_u32 s53, s53, 32768
  s_sub_u32 s55, s55, 1
  s_cmp_lg_u32 s55, 4
  s_barrier
  s_cbranch_scc1 L_ld_v
L_ld_v_done:
L_ld_e0:
  s_add_u32 s52, s53, 0
  s_add_u32 m0, s54, 0
  s_nop 0
  buffer_load_dwordx4 v3, s[24:27], s52 offen offset:0 nt lds
  buffer_load_dwordx4 v3, s[24:27], s52 offen offset:1024 nt lds
  buffer_load_dwordx4 v3, s[24:27], s52 offen offset:2048 nt lds
  buffer_load_dwordx4 v3, s[24:27], s52 offen offset:3072 nt lds
  s_add_u32 s52, s53, 4096
  s_add_u32 m0, s54, 4096
  s_nop 0
  buffer_load_dwordx4 v3, s[24:27], s52 offen offset:0 nt lds
  buffer_load_dwordx4 v3, s[24:27], s52 offen offset:1024 nt lds
  buffer_load_dwordx4 v3, s[24:27], s52 offen offset:2048 nt lds
  buffer_load_dwordx4 v3, s[24:27], s52 offen offset:3072 nt lds
  s_add_u32 s52, s53, 8192
  s_add_u32 m0, s54, 8192
  s_nop 0
  buffer_load_dwordx4 v3, s[24:27], s52 offen offset:0 nt lds
  buffer_load_dwordx4 v3, s[24:27], s52 offen offset:1024 nt lds
  buffer_load_dwordx4 v3, s[24:27], s52 offen offset:2048 nt lds
  buffer_load_dwordx4 v3, s[24:27], s52 offen offset:3072 nt lds
  s_add_u32 s52, s53, 12288
  s_add_u32 m0, s54, 12288
  s_nop 0
  buffer_load_dwordx4 v3, s[24:27], s52 offen offset:0 nt lds
  buffer_load_dwordx4 v3, s[24:27], s52 offen offset:1024 nt lds
  buffer_load_dwordx4 v3, s[24:27], s52 offen offset:2048 nt lds
  buffer_load_dwordx4 v3, s[24:27], s52 offen offset:3072 nt lds
  s_add_u32 s52, s53, 16384
  s_add_u32 m0, s54, 16384
  s_nop 0
  buffer_load_dwordx4 v3, s[24:27], s52 offen offset:0 nt lds
  buffer_load_dwordx4 v3, s[24:27], s52 offen offset:1024 nt lds
  buffer_load_dwordx4 v3, s[24:27], s52 offen offset:2048 nt lds
  buffer_load_dwordx4 v3, s[24:27], s52 offen offset:3072 nt lds
  s_add_u32 s52, s53, 20480
  s_add_u32 m0, s54, 20480
  s_nop 0
  buffer_load_dwordx4 v3, s[24:27], s52 offen offset:0 nt lds
  buffer_load_dwordx4 v3, s[24:27], s52 offen offset:1024 nt lds
  buffer_load_dwordx4 v3, s[24:27], s52 offen offset:2048 nt lds
  buffer_load_dwordx4 v3, s[24:27], s52 offen offset:3072 nt lds
  s_add_u32 s52, s53, 24576
  s_add_u32 m0, s54, 24576
  s_nop 0
  buffer_load_dwordx4 v3, s[24:27], s52 offen offset:0 nt lds
  buffer_load_dwordx4 v3, s[24:27], s52 offen offset:1024 nt lds
  buffer_load_dwordx4 v3, s[24:27], s52 offen offset:2048 nt lds
  buffer_load_dwordx4 v3, s[24:27], s52 offen offset:3072 nt lds
  s_add_u32 s52, s53, 28672
  s_add_u32 m0, s54, 28672
  s_nop 0
  buffer_load_dwordx4 v3, s[24:27], s52 offen offset:0 nt lds
  buffer_load_dwordx4 v3, s[24:27], s52 offen offset:1024 nt lds
  s_waitcnt vmcnt(61)
  buffer_load_dwordx4 v3, s[24:27], s52 offen offset:2048 nt lds
  s_waitcnt vmcnt(61)
  buffer_load_dwordx4 v3, s[24:27], s52 offen offset:3072 nt lds
  s_xor_b32 s54, s54, 32768
  s_add_u32 s53, s53, 32768
  s_sub_u32 s55, s55, 1
  s_waitcnt vmcnt(32)
  s_barrier
  s_cmp_lg_u32 s55, 0
  s_barrier
  s_cbranch_scc1 L_ld_e0
  s_waitcnt vmcnt(0)
  s_barrier
  s_endpgm
L_cons:
  s_sub_u32 s3, s3, 1
  v_and_b32 v1, 15, v0
  v_lshrrev_b32 v2, 4, v0
  v_and_b32 v3, 7, v0
  s_lshl_b32 s56, s3, 13
  v_lshlrev_b32 v30, 9, v1
  v_add_u32 v30, s56, v30
  v_lshlrev_b32 v31, 1, v2
  v_add_u32 v31, 0, v31
  v_xor_b32 v31, v31, v1
  v_lshl_add_u32 v4, v31, 4, v30
  v_lshlrev_b32 v31, 1, v2
  v_add_u32 v31, 1, v31
  v_xor_b32 v31, v31, v1
  v_lshl_add_u32 v5, v31, 4, v30
  v_lshlrev_b32 v31, 1, v2
  v_add_u32 v31, 8, v31
  v_xor_b32 v31, v31, v1
  v_lshl_add_u32 v6, v31, 4, v30
  v_lshlrev_b32 v31, 1, v2
  v_add_u32 v31, 9, v31
  v_xor_b32 v31, v31, v1
  v_lshl_add_u32 v7, v31, 4, v30
  v_lshlrev_b32 v30, 11, v2
  v_add_u32 v30, s56, v30
  v_lshl_add_u32 v8, v1, 4, v30
  v_lshlrev_b32 v30, 7, v2
  v_lshl_add_u32 v30, v3, 4, v30
  v_add_u32 v10, 143360, v30
  s_lshl_b32 s57, s3, 9
  v_add_u32 v11, s57, v10
  v_lshlrev_b32 v30, 4, v3
  v_add_u32 v12, 145408, v30
  s_lshl_b32 s57, s3, 2
  v_add_u32 v13, s57, v12
  s_lshl_b32 s57, s3, 6
  s_add_u32 s58, s57, 65536
  v_lshlrev_b32 v30, 4, v2
  v_add_u32 v14, s58, v30
  s_add_u32 s58, s57, 139264
  v_add_u32 v30, s58, v30
  v_lshl_add_u32 v16, v3, 8, v30
  s_lshl_b32 s57, s3, 5
  s_add_u32 s58, s57, 66048
  v_lshlrev_b32 v30, 3, v2
  v_add_u32 v15, s58, v30
  s_lshl_b32 s57, s3, 8
  s_add_u32 s58, s57, 65536
  v_lshlrev_b32 v30, 6, v2
  v_lshl_add_u32 v30, v3, 3, v30
  v_add_u32 v22, s58, v30
  s_lshl_b32 s57, s3, 5
  s_add_u32 s58, s57, 131072
  v_lshlrev_b32 v30, 2, v3
  v_add_u32 v23, s58, v30
  s_lshl_b32 s57, s3, 12
  s_add_u32 s57, s57, 65536
  v_lshlrev_b32 v30, 9, v3
  v_add_u32 v30, s57, v30
  v_lshrrev_b32 v31, 3, v1
  v_lshlrev_b32 v31, 4, v31
  v_lshl_add_u32 v31, v2, 2, v31
  v_add_u32 v32, 0, v31
  v_xor_b32 v32, v32, v3
  v_lshl_add_u32 v156, v32, 4, v30
  v_add_u32 v32, 1, v31
  v_xor_b32 v32, v32, v3
  v_lshl_add_u32 v157, v32, 4, v30
  v_add_u32 v32, 2, v31
  v_xor_b32 v32, v32, v3
  v_lshl_add_u32 v158, v32, 4, v30
  v_add_u32 v32, 3, v31
  v_xor_b32 v32, v32, v3
  v_lshl_add_u32 v159, v32, 4, v30
  v_cmp_le_u32 s[40:41], 8, v1
  s_lshl_b32 s57, s3, 4
  s_add_u32 s57, s57, 145536
  v_lshlrev_b32 v30, 6, v3
  v_add_u32 v18, s57, v30
  v_lshrrev_b32 v30, 5, v0
  s_lshl_b32 s57, s3, 1
  v_add_u32 v30, s57, v30
  v_and_b32 v31, 31, v0
  v_lshlrev_b32 v32, 9, v30
  v_xor_b32 v33, v31, v30
  v_lshl_add_u32 v32, v33, 4, v32
  v_add_u32 v19, 65536, v32
  v_lshlrev_b32 v32, 6, v30
  v_add_u32 v20, 145536, v32
  v_lshlrev_b32 v32, 8, v30
  v_lshl_add_u32 v21, v31, 3, v32
  s_waitcnt lgkmcnt(0)
  s_mov_b32 s48, s18
  s_and_b32 s49, s19, 0xffff
  s_mov_b32 s50, 0x100000
  s_mov_b32 s51, 0x20000
  s_cmp_ge_u32 s2, 32
  s_cbranch_scc1 L_noinit
  s_cmp_lg_u32 s3, 0
  s_cbranch_scc1 L_noinit
  s_mul_i32 s57, s2, 17408
  s_add_u32 s82, s80, s57
  s_addc_u32 s83, s81, 0
  s_add_u32 s82, s82, 1048576
  s_addc_u32 s83, s83, 0
  v_mul_u32_u24 v30, 4352, v0
  v_mov_b32 v32, 0
  s_mov_b64 exec, 15
  global_store_dword v30, v32, s[82:83] sc0 sc1
  s_mov_b64 exec, -1
  s_nop 0
L_noinit:
  s_lshl_b32 s59, s2, 12
  s_mov_b32 s60, 0
  s_mov_b32 s61, 0x3e0293ee
  s_mov_b32 s62, 0xffff0000
  s_mov_b32 s63, 32768
  v_mov_b32 v24, 0xff61b1e6
  v_mov_b32 v25, 0
  v_mov_b32 v27, 0
  v_mov_b32 v160, 0
  v_mov_b32 v161, 0
  v_mov_b32 v162, 0
  v_mov_b32 v163, 0
  v_mov_b32 v164, 0
  v_mov_b32 v165, 0
  v_mov_b32 v166, 0
  v_mov_b32 v167, 0
  v_mov_b32 v168, 0
  v_mov_b32 v169, 0
  v_mov_b32 v170, 0
  v_mov_b32 v171, 0
  v_mov_b32 v172, 0
  v_mov_b32 v173, 0
  v_mov_b32 v174, 0
  v_mov_b32 v175, 0
  v_mov_b32 v176, 0
  v_mov_b32 v177, 0
  v_mov_b32 v178, 0
  v_mov_b32 v179, 0
  v_mov_b32 v180, 0
  v_mov_b32 v181, 0
  v_mov_b32 v182, 0
  v_mov_b32 v183, 0
  v_mov_b32 v184, 0
  v_mov_b32 v185, 0
  v_mov_b32 v186, 0
  v_mov_b32 v187, 0
  v_mov_b32 v188, 0
  v_mov_b32 v189, 0
  v_mov_b32 v190, 0
  v_mov_b32 v191, 0
  v_mov_b32 v192, 0
  v_mov_b32 v193, 0
  v_mov_b32 v194, 0
  v_mov_b32 v195, 0
  s_barrier
  ds_read_b128 v[130:133], v14
  ds_read_b128 v[134:137], v14 offset:256
  ds_read_b128 v[30:33], v16 offset:0
  s_waitcnt lgkmcnt(0)
  v_lshlrev_b32 v40, 16, v30
  v_and_b32 v41, s62, v30
  v_lshlrev_b32 v42, 16, v31
  v_and_b32 v43, s62, v31
  v_lshlrev_b32 v44, 16, v32
  v_and_b32 v45, s62, v32
  v_lshlrev_b32 v46, 16, v33
  v_and_b32 v47, s62, v33
  v_mul_f32 v40, s61, v40
  v_mul_f32 v41, s61, v41
  v_mul_f32 v42, s61, v42
  v_mul_f32 v43, s61, v43
  v_mul_f32 v44, s61, v44
  v_mul_f32 v45, s61, v45
  v_mul_f32 v46, s61, v46
  v_mul_f32 v47, s61, v47
  v_lshlrev_b32 v138, 16, v130
  v_and_b32 v139, s62, v130
  v_lshlrev_b32 v140, 16, v131
  v_and_b32 v141, s62, v131
  v_lshlrev_b32 v142, 16, v132
  v_and_b32 v143, s62, v132
  v_lshlrev_b32 v144, 16, v133
  v_and_b32 v145, s62, v133
  v_mul_f32 v138, v40, v138
  v_mul_f32 v139, v41, v139
  v_mul_f32 v140, v42, v140
  v_mul_f32 v141, v43, v141
  v_mul_f32 v142, v44, v142
  v_mul_f32 v143, v45, v143
  v_mul_f32 v144, v46, v144
  v_mul_f32 v145, v47, v145
  v_cvt_pk_bf16_f32 v146, v138, v139
  v_cvt_pk_bf16_f32 v147, v140, v141
  v_cvt_pk_bf16_f32 v148, v142, v143
  v_cvt_pk_bf16_f32 v149, v144, v145
  s_nop 1
  v_mfma_f32_16x16x32_bf16 v[150:153], v[134:137], v[146:149], 0
  v_add_u32 v14, 1024, v14
  ds_write_b128 v11, v[146:149]
  s_nop 5
  ds_write_b32 v13, v150
  s_waitcnt lgkmcnt(0)
  s_barrier
L_p1:
  s_barrier
  ds_read_b128 v[96:99], v10 offset:0
  ds_read_b128 v[48:51], v4 offset:0
  ds_read_b128 v[52:55], v5 offset:0
  ds_read_b128 v[100:103], v10 offset:512
  ds_read_b128 v[56:59], v6 offset:0
  ds_read_b128 v[60:63], v7 offset:0
  ds_read_b128 v[104:107], v10 offset:1024
  ds_read_b128 v[64:67], v4 offset:256
  ds_read_b128 v[68:71], v5 offset:256
  ds_read_b128 v[108:111], v10 offset:1536
  ds_read_b128 v[72:75], v6 offset:256
  ds_read_b128 v[76:79], v7 offset:256
  ds_read_b128 v[116:119], v12
  ds_read_b64 v[120:121], v15
  ds_read_b64 v[122:123], v15 offset:128
  v_xor_b32 v4, s63, v4
  v_xor_b32 v5, s63, v5
  v_xor_b32 v6, s63, v6
  v_xor_b32 v7, s63, v7
  v_add_u32 v15, 1024, v15
  s_waitcnt lgkmcnt(12)
  v_cvt_f32_i32 v48, v48
  v_cvt_f32_i32 v49, v49
  v_cvt_f32_i32 v50, v50
  v_cvt_f32_i32 v51, v51
  v_cvt_f32_i32 v52, v52
  v_cvt_f32_i32 v53, v53
  v_cvt_f32_i32 v54, v54
  v_cvt_f32_i32 v55, v55
  v_cvt_pk_bf16_f32 v80, v48, v49
  v_cvt_pk_bf16_f32 v81, v50, v51
  v_cvt_pk_bf16_f32 v82, v52, v53
  v_cvt_pk_bf16_f32 v83, v54, v55
  s_nop 1
  v_mfma_f32_16x16x32_bf16 v[112:115], v[80:83], v[96:99], 0
  s_waitcnt lgkmcnt(9)
  v_cvt_f32_i32 v56, v56
  v_cvt_f32_i32 v57, v57
  v_cvt_f32_i32 v58, v58
  v_cvt_f32_i32 v59, v59
  v_cvt_f32_i32 v60, v60
  v_cvt_f32_i32 v61, v61
  v_cvt_f32_i32 v62, v62
  v_cvt_f32_i32 v63, v63
  v_cvt_pk_bf16_f32 v84, v56, v57
  v_cvt_pk_bf16_f32 v85, v58, v59
  v_cvt_pk_bf16_f32 v86, v60, v61
  v_cvt_pk_bf16_f32 v87, v62, v63
  s_nop 1
  v_mfma_f32_16x16x32_bf16 v[112:115], v[84:87], v[100:103], v[112:115]
  s_waitcnt lgkmcnt(0)
  s_barrier
  ds_read_b128 v[130:133], v14
  ds_read_b128 v[134:137], v14 offset:256
  v_cvt_f32_i32 v64, v64
  v_cvt_f32_i32 v65, v65
  v_cvt_f32_i32 v66, v66
  v_cvt_f32_i32 v67, v67
  v_cvt_f32_i32 v68, v68
  v_cvt_f32_i32 v69, v69
  v_cvt_f32_i32 v70, v70
  v_cvt_f32_i32 v71, v71
  v_cvt_pk_bf16_f32 v88, v64, v65
  v_cvt_pk_bf16_f32 v89, v66, v67
  v_cvt_pk_bf16_f32 v90, v68, v69
  v_cvt_pk_bf16_f32 v91, v70, v71
  s_nop 1
  v_mfma_f32_16x16x32_bf16 v[112:115], v[88:91], v[104:107], v[112:115]
  v_cvt_f32_i32 v72, v72
  v_cvt_f32_i32 v73, v73
  v_cvt_f32_i32 v74, v74
  v_cvt_f32_i32 v75, v75
  v_cvt_f32_i32 v76, v76
  v_cvt_f32_i32 v77, v77
  v_cvt_f32_i32 v78, v78
  v_cvt_f32_i32 v79, v79
  v_cvt_pk_bf16_f32 v92, v72, v73
  v_cvt_pk_bf16_f32 v93, v74, v75
  v_cvt_pk_bf16_f32 v94, v76, v77
  v_cvt_pk_bf16_f32 v95, v78, v79
  s_nop 1
  v_mfma_f32_16x16x32_bf16 v[112:115], v[92:95], v[108:111], v[112:115]
  s_waitcnt lgkmcnt(0)
  v_add_f32 v116, v116, v117
  v_add_f32 v118, v118, v119
  v_add_f32 v29, v116, v118
  v_lshlrev_b32 v34, 16, v120
  v_and_b32 v35, s62, v120
  v_lshlrev_b32 v36, 16, v121
  v_and_b32 v37, s62, v121
  v_max3_f32 v30, v112, v113, v114
  v_max_f32 v30, v30, v115
  v_mov_b32 v31, v30
  s_nop 1
  v_permlane32_swap_b32 v31, v30
  v_max_f32 v30, v30, v31
  v_mov_b32 v31, v30
  s_nop 1
  v_permlane16_swap_b32 v31, v30
  v_max_f32 v30, v30, v31
  v_sub_f32 v30, v30, v29
  v_max_f32 v30, v30, v24
  v_sub_f32 v28, v24, v30
  v_add_f32 v31, v29, v30
  v_mov_b32 v24, v30
  v_mov_b32 v154, v30
  v_exp_f32 v28, v28
  v_sub_f32 v126, v112, v31
  v_sub_f32 v127, v113, v31
  v_sub_f32 v128, v114, v31
  v_sub_f32 v129, v115, v31
  v_exp_f32 v126, v126
  v_exp_f32 v127, v127
  v_exp_f32 v128, v128
  v_exp_f32 v129, v129
  v_mul_f32 v192, v28, v192
  v_mul_f32 v193, v28, v193
  v_mul_f32 v194, v28, v194
  v_mul_f32 v195, v28, v195
  v_add_f32 v32, v126, v127
  v_add_f32 v33, v128, v129
  v_add_f32 v32, v32, v33
  v_fma_f32 v25, v25, v28, v32
  v_mul_f32 v126, v126, v34
  v_mul_f32 v127, v127, v35
  v_mul_f32 v128, v128, v36
  v_mul_f32 v129, v129, v37
  v_cvt_pk_bf16_f32 v124, v126, v127
  v_cvt_pk_bf16_f32 v125, v128, v129
  s_nop 1
  v_mfma_f32_16x16x16_bf16 v[192:195], v[122:123], v[124:125], v[192:195]
  s_and_b32 s57, s60, 31
  s_cmp_lg_u32 s57, 31
  s_nop 5
  s_cbranch_scc1 L_p1_nofin
  v_mov_b32 v31, v25
  s_nop 1
  v_permlane32_swap_b32 v31, v25
  v_add_f32 v25, v25, v31
  v_mov_b32 v31, v25
  s_nop 1
  v_permlane16_swap_b32 v31, v25
  v_add_f32 v25, v25, v31
  v_mov_b32 v26, v192
  ds_write_b128 v18, v[24:27]
  v_add_u32 v18, 512, v18
  ds_read_b128 v[30:33], v16 offset:2048
  s_waitcnt lgkmcnt(0)
  v_lshlrev_b32 v40, 16, v30
  v_and_b32 v41, s62, v30
  v_lshlrev_b32 v42, 16, v31
  v_and_b32 v43, s62, v31
  v_lshlrev_b32 v44, 16, v32
  v_and_b32 v45, s62, v32
  v_lshlrev_b32 v46, 16, v33
  v_and_b32 v47, s62, v33
  v_mul_f32 v40, s61, v40
  v_mul_f32 v41, s61, v41
  v_mul_f32 v42, s61, v42
  v_mul_f32 v43, s61, v43
  v_mul_f32 v44, s61, v44
  v_mul_f32 v45, s61, v45
  v_mul_f32 v46, s61, v46
  v_mul_f32 v47, s61, v47
  v_mov_b32 v24, 0xff61b1e6
  v_mov_b32 v25, 0
  v_mov_b32 v192, 0
  v_mov_b32 v193, 0
  v_mov_b32 v194, 0
  v_mov_b32 v195, 0
  s_nop 1
L_p1_nofin:
  v_lshlrev_b32 v138, 16, v130
  v_and_b32 v139, s62, v130
  v_lshlrev_b32 v140, 16, v131
  v_and_b32 v141, s62, v131
  v_lshlrev_b32 v142, 16, v132
  v_and_b32 v143, s62, v132
  v_lshlrev_b32 v144, 16, v133
  v_and_b32 v145, s62, v133
  v_mul_f32 v138, v40, v138
  v_mul_f32 v139, v41, v139
  v_mul_f32 v140, v42, v140
  v_mul_f32 v141, v43, v141
  v_mul_f32 v142, v44, v142
  v_mul_f32 v143, v45, v143
  v_mul_f32 v144, v46, v144
  v_mul_f32 v145, v47, v145
  v_cvt_pk_bf16_f32 v146, v138, v139
  v_cvt_pk_bf16_f32 v147, v140, v141
  v_cvt_pk_bf16_f32 v148, v142, v143
  v_cvt_pk_bf16_f32 v149, v144, v145
  s_nop 1
  v_mfma_f32_16x16x32_bf16 v[150:153], v[134:137], v[146:149], 0
  v_add_u32 v14, 1024, v14
  s_add_u32 s60, s60, 1
  ds_write_b64 v22, v[124:125]
  ds_write_b32 v23, v154
  ds_write_b128 v11, v[146:149]
  s_nop 2
  ds_write_b32 v13, v150
  v_add_u32 v22, 1024, v22
  v_add_u32 v23, 128, v23
  s_cmp_lg_u32 s60, 64
  s_waitcnt lgkmcnt(0)
  s_cbranch_scc1 L_p1
  v_subrev_u32 v22, 65536, v22
  v_subrev_u32 v23, 8192, v23
  s_mov_b32 s60, 0
  ds_read_b64 v[124:125], v22
  ds_read_b32 v154, v23
  v_add_u32 v22, 1024, v22
  v_add_u32 v23, 128, v23
  s_waitcnt lgkmcnt(0)
  v_sub_f32 v28, v24, v154
  v_exp_f32 v28, v28
  v_mov_b32 v24, v154
  v_mul_f32 v160, v28, v160
  v_mul_f32 v161, v28, v161
  v_mul_f32 v162, v28, v162
  v_mul_f32 v163, v28, v163
  v_mul_f32 v164, v28, v164
  v_mul_f32 v165, v28, v165
  v_mul_f32 v166, v28, v166
  v_mul_f32 v167, v28, v167
  v_mul_f32 v168, v28, v168
  v_mul_f32 v169, v28, v169
  v_mul_f32 v170, v28, v170
  v_mul_f32 v171, v28, v171
  v_mul_f32 v172, v28, v172
  v_mul_f32 v173, v28, v173
  v_mul_f32 v174, v28, v174
  v_mul_f32 v175, v28, v175
  v_mul_f32 v176, v28, v176
  v_mul_f32 v177, v28, v177
  v_mul_f32 v178, v28, v178
  v_mul_f32 v179, v28, v179
  v_mul_f32 v180, v28, v180
  v_mul_f32 v181, v28, v181
  v_mul_f32 v182, v28, v182
  v_mul_f32 v183, v28, v183
  v_mul_f32 v184, v28, v184
  v_mul_f32 v185, v28, v185
  v_mul_f32 v186, v28, v186
  v_mul_f32 v187, v28, v187
  v_mul_f32 v188, v28, v188
  v_mul_f32 v189, v28, v189
  v_mul_f32 v190, v28, v190
  v_mul_f32 v191, v28, v191
  s_nop 1
L_p2:
  s_barrier
  ds_read_b128 v[48:51], v8 offset:0
  ds_read_b128 v[56:59], v8 offset:512
  ds_read_b128 v[64:67], v8 offset:1024
  ds_read_b128 v[72:75], v8 offset:1536
  ds_read_b128 v[52:55], v8 offset:256
  ds_read_b128 v[60:63], v8 offset:768
  ds_read_b128 v[68:71], v8 offset:1280
  ds_read_b128 v[76:79], v8 offset:1792
  v_xor_b32 v8, s63, v8
  s_waitcnt lgkmcnt(4)
  v_cvt_f32_i32 v48, v48
  v_cvt_f32_i32 v56, v56
  v_cvt_f32_i32 v64, v64
  v_cvt_f32_i32 v72, v72
  v_cvt_pk_bf16_f32 v80, v48, v56
  v_cvt_pk_bf16_f32 v81, v64, v72
  v_cvt_f32_i32 v49, v49
  v_cvt_f32_i32 v57, v57
  v_cvt_f32_i32 v65, v65
  v_cvt_f32_i32 v73, v73
  v_cvt_pk_bf16_f32 v82, v49, v57
  v_cvt_pk_bf16_f32 v83, v65, v73
  v_mfma_f32_16x16x16_bf16 v[160:163], v[80:81], v[124:125], v[160:163]
  v_cvt_f32_i32 v50, v50
  v_cvt_f32_i32 v58, v58
  v_cvt_f32_i32 v66, v66
  v_cvt_f32_i32 v74, v74
  v_cvt_pk_bf16_f32 v84, v50, v58
  v_cvt_pk_bf16_f32 v85, v66, v74
  v_mfma_f32_16x16x16_bf16 v[164:167], v[82:83], v[124:125], v[164:167]
  v_cvt_f32_i32 v51, v51
  v_cvt_f32_i32 v59, v59
  v_cvt_f32_i32 v67, v67
  v_cvt_f32_i32 v75, v75
  v_cvt_pk_bf16_f32 v86, v51, v59
  v_cvt_pk_bf16_f32 v87, v67, v75
  v_mfma_f32_16x16x16_bf16 v[168:171], v[84:85], v[124:125], v[168:171]
  s_nop 0
  v_mfma_f32_16x16x16_bf16 v[172:175], v[86:87], v[124:125], v[172:175]
  s_waitcnt lgkmcnt(0)
  s_barrier
  v_cvt_f32_i32 v52, v52
  v_cvt_f32_i32 v60, v60
  v_cvt_f32_i32 v68, v68
  v_cvt_f32_i32 v76, v76
  v_cvt_pk_bf16_f32 v88, v52, v60
  v_cvt_pk_bf16_f32 v89, v68, v76
  v_cvt_f32_i32 v53, v53
  v_cvt_f32_i32 v61, v61
  v_cvt_f32_i32 v69, v69
  v_cvt_f32_i32 v77, v77
  v_cvt_pk_bf16_f32 v90, v53, v61
  v_cvt_pk_bf16_f32 v91, v69, v77
  v_mfma_f32_16x16x16_bf16 v[176:179], v[88:89], v[124:125], v[176:179]
  v_cvt_f32_i32 v54, v54
  v_cvt_f32_i32 v62, v62
  v_cvt_f32_i32 v70, v70
  v_cvt_f32_i32 v78, v78
  v_cvt_pk_bf16_f32 v92, v54, v62
  v_cvt_pk_bf16_f32 v93, v70, v78
  v_mfma_f32_16x16x16_bf16 v[180:183], v[90:91], v[124:125], v[180:183]
  v_cvt_f32_i32 v55, v55
  v_cvt_f32_i32 v63, v63
  v_cvt_f32_i32 v71, v71
  v_cvt_f32_i32 v79, v79
  v_cvt_pk_bf16_f32 v94, v55, v63
  v_cvt_pk_bf16_f32 v95, v71, v79
  v_mfma_f32_16x16x16_bf16 v[184:187], v[92:93], v[124:125], v[184:187]
  s_nop 0
  v_mfma_f32_16x16x16_bf16 v[188:191], v[94:95], v[124:125], v[188:191]
  s_cmp_lg_u32 s60, 32
  s_nop 6
  s_cbranch_scc1 L_p2_nocomb
  ds_read_b128 v[48:51], v19 offset:0
  ds_read_b128 v[52:55], v19 offset:4096
  ds_read_b128 v[56:59], v19 offset:8192
  ds_read_b128 v[60:63], v19 offset:12288
  s_waitcnt lgkmcnt(3)
  v_fma_f32 v36, v96, v48, -v100
  v_fma_f32 v37, v96, v49, -v100
  v_fma_f32 v38, v96, v50, -v100
  v_fma_f32 v39, v96, v51, -v100
  s_waitcnt lgkmcnt(2)
  v_fmac_f32 v36, v97, v52
  v_fmac_f32 v37, v97, v53
  v_fmac_f32 v38, v97, v54
  v_fmac_f32 v39, v97, v55
  s_waitcnt lgkmcnt(1)
  v_fmac_f32 v36, v98, v56
  v_fmac_f32 v37, v98, v57
  v_fmac_f32 v38, v98, v58
  v_fmac_f32 v39, v98, v59
  s_waitcnt lgkmcnt(0)
  v_fmac_f32 v36, v99, v60
  v_fmac_f32 v37, v99, v61
  v_fmac_f32 v38, v99, v62
  v_fmac_f32 v39, v99, v63
  v_cvt_pk_bf16_f32 v30, v36, v37
  v_cvt_pk_bf16_f32 v31, v38, v39
  buffer_store_dwordx2 v[30:31], v21, s[48:51], s59 offen
  s_add_u32 s59, s59, 2048
  ds_read_b128 v[48:51], v20 offset:512
  ds_read_b128 v[52:55], v20 offset:528
  ds_read_b128 v[56:59], v20 offset:544
  ds_read_b128 v[60:63], v20 offset:560
  s_waitcnt lgkmcnt(0)
  v_max3_f32 v30, v48, v52, v56
  v_max_f32 v30, v30, v60
  v_sub_f32 v96, v48, v30
  v_sub_f32 v97, v52, v30
  v_sub_f32 v98, v56, v30
  v_sub_f32 v99, v60, v30
  v_exp_f32 v96, v96
  v_exp_f32 v97, v97
  v_exp_f32 v98, v98
  v_exp_f32 v99, v99
  v_mul_f32 v35, v96, v49
  v_fmac_f32 v35, v97, v53
  v_fmac_f32 v35, v98, v57
  v_fmac_f32 v35, v99, v61
  v_rcp_f32 v35, v35
  s_nop 0
  v_mul_f32 v96, v96, v35
  v_mul_f32 v97, v97, v35
  v_mul_f32 v98, v98, v35
  v_mul_f32 v99, v99, v35
  v_mul_f32 v100, v96, v50
  v_fmac_f32 v100, v97, v54
  v_fmac_f32 v100, v98, v58
  v_fmac_f32 v100, v99, v62
  s_nop 1
L_p2_nocomb:
  s_cmp_lg_u32 s60, 4
  s_cbranch_scc1 L_p2_now0
  ds_read_b128 v[48:51], v20 offset:0
  ds_read_b128 v[52:55], v20 offset:16
  ds_read_b128 v[56:59], v20 offset:32
  ds_read_b128 v[60:63], v20 offset:48
  s_waitcnt lgkmcnt(0)
  v_max3_f32 v30, v48, v52, v56
  v_max_f32 v30, v30, v60
  v_sub_f32 v96, v48, v30
  v_sub_f32 v97, v52, v30
  v_sub_f32 v98, v56, v30
  v_sub_f32 v99, v60, v30
  v_exp_f32 v96, v96
  v_exp_f32 v97, v97
  v_exp_f32 v98, v98
  v_exp_f32 v99, v99
  v_mul_f32 v35, v96, v49
  v_fmac_f32 v35, v97, v53
  v_fmac_f32 v35, v98, v57
  v_fmac_f32 v35, v99, v61
  v_rcp_f32 v35, v35
  s_nop 0
  v_mul_f32 v96, v96, v35
  v_mul_f32 v97, v97, v35
  v_mul_f32 v98, v98, v35
  v_mul_f32 v99, v99, v35
  v_mul_f32 v100, v96, v50
  v_fmac_f32 v100, v97, v54
  v_fmac_f32 v100, v98, v58
  v_fmac_f32 v100, v99, v62
  s_nop 1
L_p2_now0:
  s_and_b32 s57, s60, 31
  s_cmp_lg_u32 s57, 31
  s_cbranch_scc1 L_p2_nofin
  v_cndmask_b32 v48, v160, v176, s[40:41]
  v_cndmask_b32 v49, v164, v180, s[40:41]
  v_cndmask_b32 v50, v168, v184, s[40:41]
  v_cndmask_b32 v51, v172, v188, s[40:41]
  ds_write_b128 v156, v[48:51]
  v_cndmask_b32 v52, v161, v177, s[40:41]
  v_cndmask_b32 v53, v165, v181, s[40:41]
  v_cndmask_b32 v54, v169, v185, s[40:41]
  v_cndmask_b32 v55, v173, v189, s[40:41]
  ds_write_b128 v157, v[52:55]
  v_cndmask_b32 v56, v162, v178, s[40:41]
  v_cndmask_b32 v57, v166, v182, s[40:41]
  v_cndmask_b32 v58, v170, v186, s[40:41]
  v_cndmask_b32 v59, v174, v190, s[40:41]
  ds_write_b128 v158, v[56:59]
  v_cndmask_b32 v60, v163, v179, s[40:41]
  v_cndmask_b32 v61, v167, v183, s[40:41]
  v_cndmask_b32 v62, v171, v187, s[40:41]
  v_cndmask_b32 v63, v175, v191, s[40:41]
  ds_write_b128 v159, v[60:63]
  s_cmp_eq_u32 s60, 63
  s_cbranch_scc1 L_fin
  v_mov_b32 v24, 0xff61b1e6
  v_mov_b32 v160, 0
  v_mov_b32 v161, 0
  v_mov_b32 v162, 0
  v_mov_b32 v163, 0
  v_mov_b32 v164, 0
  v_mov_b32 v165, 0
  v_mov_b32 v166, 0
  v_mov_b32 v167, 0
  v_mov_b32 v168, 0
  v_mov_b32 v169, 0
  v_mov_b32 v170, 0
  v_mov_b32 v171, 0
  v_mov_b32 v172, 0
  v_mov_b32 v173, 0
  v_mov_b32 v174, 0
  v_mov_b32 v175, 0
  v_mov_b32 v176, 0
  v_mov_b32 v177, 0
  v_mov_b32 v178, 0
  v_mov_b32 v179, 0
  v_mov_b32 v180, 0
  v_mov_b32 v181, 0
  v_mov_b32 v182, 0
  v_mov_b32 v183, 0
  v_mov_b32 v184, 0
  v_mov_b32 v185, 0
  v_mov_b32 v186, 0
  v_mov_b32 v187, 0
  v_mov_b32 v188, 0
  v_mov_b32 v189, 0
  v_mov_b32 v190, 0
  v_mov_b32 v191, 0
  s_nop 1
L_p2_nofin:
  ds_read_b64 v[124:125], v22
  ds_read_b32 v154, v23
  v_add_u32 v22, 1024, v22
  v_add_u32 v23, 128, v23
  s_waitcnt lgkmcnt(0)
  v_sub_f32 v28, v24, v154
  v_exp_f32 v28, v28
  v_mov_b32 v24, v154
  v_mul_f32 v160, v28, v160
  v_mul_f32 v161, v28, v161
  v_mul_f32 v162, v28, v162
  v_mul_f32 v163, v28, v163
  v_mul_f32 v164, v28, v164
  v_mul_f32 v165, v28, v165
  v_mul_f32 v166, v28, v166
  v_mul_f32 v167, v28, v167
  v_mul_f32 v168, v28, v168
  v_mul_f32 v169, v28, v169
  v_mul_f32 v170, v28, v170
  v_mul_f32 v171, v28, v171
  v_mul_f32 v172, v28, v172
  v_mul_f32 v173, v28, v173
  v_mul_f32 v174, v28, v174
  v_mul_f32 v175, v28, v175
  v_mul_f32 v176, v28, v176
  v_mul_f32 v177, v28, v177
  v_mul_f32 v178, v28, v178
  v_mul_f32 v179, v28, v179
  v_mul_f32 v180, v28, v180
  v_mul_f32 v181, v28, v181
  v_mul_f32 v182, v28, v182
  v_mul_f32 v183, v28, v183
  v_mul_f32 v184, v28, v184
  v_mul_f32 v185, v28, v185
  v_mul_f32 v186, v28, v186
  v_mul_f32 v187, v28, v187
  v_mul_f32 v188, v28, v188
  v_mul_f32 v189, v28, v189
  v_mul_f32 v190, v28, v190
  v_mul_f32 v191, v28, v191
  s_add_u32 s60, s60, 1
  s_nop 0
  s_branch L_p2
L_fin:
  s_waitcnt lgkmcnt(0)
  s_barrier
  ds_read_b128 v[48:51], v19 offset:0
  ds_read_b128 v[52:55], v19 offset:4096
  ds_read_b128 v[56:59], v19 offset:8192
  ds_read_b128 v[60:63], v19 offset:12288
  s_waitcnt lgkmcnt(3)
  v_fma_f32 v36, v96, v48, -v100
  v_fma_f32 v37, v96, v49, -v100
  v_fma_f32 v38, v96, v50, -v100
  v_fma_f32 v39, v96, v51, -v100
  s_waitcnt lgkmcnt(2)
  v_fmac_f32 v36, v97, v52
  v_fmac_f32 v37, v97, v53
  v_fmac_f32 v38, v97, v54
  v_fmac_f32 v39, v97, v55
  s_waitcnt lgkmcnt(1)
  v_fmac_f32 v36, v98, v56
  v_fmac_f32 v37, v98, v57
  v_fmac_f32 v38, v98, v58
  v_fmac_f32 v39, v98, v59
  s_waitcnt lgkmcnt(0)
  v_fmac_f32 v36, v99, v60
  v_fmac_f32 v37, v99, v61
  v_fmac_f32 v38, v99, v62
  v_fmac_f32 v39, v99, v63
  v_cvt_pk_bf16_f32 v30, v36, v37
  v_cvt_pk_bf16_f32 v31, v38, v39
  buffer_store_dwordx2 v[30:31], v21, s[48:51], s59 offen
  s_add_u32 s59, s59, 2048
  s_nop 0
L_end:
  s_endpgm
.section .rodata,"a"
.p2align 6
.amdhsa_kernel standalone__kv_cache_quant_int4_int2_kv_with_per_channel_or_per_token_scales__sampling_kernel
  .amdhsa_next_free_vgpr 200
  .amdhsa_next_free_sgpr 102
  .amdhsa_accum_offset 200
  .amdhsa_group_segment_fixed_size 0
  .amdhsa_kernarg_size 80
  .amdhsa_user_sgpr_count 2
  .amdhsa_user_sgpr_kernarg_segment_ptr 1
  .amdhsa_system_sgpr_workgroup_id_x 1
.end_amdhsa_kernel
```
